```python
import torch

def _softmax(x, axis=-1):
    return torch.softmax(x, dim=axis)
def _gelu(x):
    return torch.nn.functional.gelu(x, approximate="tanh")
def _silu(x):
    return torch.nn.functional.silu(x)
def _sigmoid(x):
    return torch.sigmoid(x)
def _layernorm(x, axis=-1, eps=1e-5):
    m = x.mean(dim=axis, keepdim=True)
    v = x.var(dim=axis, keepdim=True, unbiased=False)
    return (x - m) / torch.sqrt(v + eps)
def _scatter_add(tgt, idx, src, axis=0):
    return tgt.clone().index_add_(axis, idx, src)
def _segment_sum(src, seg, n):
    out = torch.zeros((n,) + src.shape[1:], dtype=src.dtype)
    return out.index_add_(0, seg, src)
def _pad(x, pw):
    flat = tuple(v for pair in reversed(pw) for v in pair)
    return torch.nn.functional.pad(x, flat)

kernel_name = 'standalone__rmsnorm__sampling'

def setup_inputs():

    _w = (lambda a: (lambda t: t.to(torch.bfloat16) if t.is_floating_point() else t)(torch.as_tensor(a)))
    B, S, D = 1024, 32, 448
    return {
        "x": _w((lambda *s: torch.randn(*s, dtype=torch.bfloat16) * 0.05)(B, S, D)),
        "g": _w((lambda *s: torch.randn(*s, dtype=torch.bfloat16) * 0.05)(D) + 1.0),
    }

def reference(x, g):
    rms = torch.sqrt((x * x).mean(axis=-1, keepdims=True) + 1e-6)
    return x / rms * g
```

```asm
; @launch grid=(256,1,1) block=(1024,1,1) lds=1792
.amdgcn_target "amdgcn-amd-amdhsa--gfx950"
.text
.globl standalone__rmsnorm__sampling_kernel
.p2align 8
.type standalone__rmsnorm__sampling_kernel,@function
standalone__rmsnorm__sampling_kernel:
    s_load_dwordx4 s[4:7], s[0:1], 0
    s_load_dwordx2 s[8:9], s[0:1], 16
    s_cmpk_ge_u32 s2, 256
    s_cbranch_scc1 L_end
    v_readfirstlane_b32 s11, v0
    v_bfe_u32 v1, v0, 3, 3
    v_and_b32 v2, 7, v0
    v_and_b32 v3, 63, v0
    s_lshr_b32 s11, s11, 6
    v_mul_u32_u24 v1, 896, v1
    s_lshl_b32 s3, s11, 8
    v_lshlrev_b32 v2, 4, v2
    s_add_u32 s3, s3, s2
    v_min_u32 v3, 55, v3
    s_mul_i32 s3, s3, 7168
    v_lshlrev_b32 v92, 4, v3
    v_add3_u32 v1, v1, v2, s3
    s_mov_b32 s10, 0xffff0000
    s_waitcnt lgkmcnt(0)
    global_load_dwordx4 v[32:35], v92, s[6:7]
    global_load_dwordx4 v[4:7], v1, s[4:5] offset:0 nt
    global_load_dwordx4 v[8:11], v1, s[4:5] offset:128 nt
    global_load_dwordx4 v[12:15], v1, s[4:5] offset:256 nt
    global_load_dwordx4 v[16:19], v1, s[4:5] offset:384 nt
    global_load_dwordx4 v[20:23], v1, s[4:5] offset:512 nt
    global_load_dwordx4 v[24:27], v1, s[4:5] offset:640 nt
    global_load_dwordx4 v[28:31], v1, s[4:5] offset:768 nt
    s_cmp_lt_u32 s11, 12
    s_cbranch_scc1 L_old
    s_barrier
L_old:
    v_lshlrev_b32 v3, 5, v3
    v_lshlrev_b32 v2, 1, v2
    v_mov_b32 v88, 0
    v_mov_b32 v89, 0
    v_mov_b32 v90, 0
    v_mov_b32 v91, 0
    s_waitcnt vmcnt(7)
    v_lshlrev_b32 v92, 16, v32
    v_and_b32 v93, s10, v32
    v_lshlrev_b32 v94, 16, v33
    v_and_b32 v95, s10, v33
    v_lshlrev_b32 v96, 16, v34
    v_and_b32 v97, s10, v34
    v_lshlrev_b32 v98, 16, v35
    v_and_b32 v99, s10, v35
    ds_write_b128 v3, v[92:95]
    ds_write_b128 v3, v[96:99] offset:16
    s_waitcnt lgkmcnt(0)
    ds_read_b128 v[32:35], v2 offset:0
    ds_read_b128 v[36:39], v2 offset:16
    ds_read_b128 v[40:43], v2 offset:256
    ds_read_b128 v[44:47], v2 offset:272
    ds_read_b128 v[48:51], v2 offset:512
    ds_read_b128 v[52:55], v2 offset:528
    ds_read_b128 v[56:59], v2 offset:768
    ds_read_b128 v[60:63], v2 offset:784
    ds_read_b128 v[64:67], v2 offset:1024
    ds_read_b128 v[68:71], v2 offset:1040
    ds_read_b128 v[72:75], v2 offset:1280
    ds_read_b128 v[76:79], v2 offset:1296
    ds_read_b128 v[80:83], v2 offset:1536
    ds_read_b128 v[84:87], v2 offset:1552
    s_waitcnt vmcnt(6)
    v_dot2c_f32_bf16 v88, v4, v4
    v_dot2c_f32_bf16 v89, v5, v5
    v_dot2c_f32_bf16 v90, v6, v6
    v_dot2c_f32_bf16 v91, v7, v7
    s_waitcnt vmcnt(5)
    v_dot2c_f32_bf16 v88, v8, v8
    v_dot2c_f32_bf16 v89, v9, v9
    v_dot2c_f32_bf16 v90, v10, v10
    v_dot2c_f32_bf16 v91, v11, v11
    s_waitcnt vmcnt(4)
    v_dot2c_f32_bf16 v88, v12, v12
    v_dot2c_f32_bf16 v89, v13, v13
    v_dot2c_f32_bf16 v90, v14, v14
    v_dot2c_f32_bf16 v91, v15, v15
    s_waitcnt vmcnt(3)
    v_dot2c_f32_bf16 v88, v16, v16
    v_dot2c_f32_bf16 v89, v17, v17
    v_dot2c_f32_bf16 v90, v18, v18
    v_dot2c_f32_bf16 v91, v19, v19
    s_waitcnt vmcnt(2)
    v_dot2c_f32_bf16 v88, v20, v20
    v_dot2c_f32_bf16 v89, v21, v21
    v_dot2c_f32_bf16 v90, v22, v22
    v_dot2c_f32_bf16 v91, v23, v23
    s_waitcnt vmcnt(1)
    v_dot2c_f32_bf16 v88, v24, v24
    v_dot2c_f32_bf16 v89, v25, v25
    v_dot2c_f32_bf16 v90, v26, v26
    v_dot2c_f32_bf16 v91, v27, v27
    s_waitcnt vmcnt(0)
    v_dot2c_f32_bf16 v88, v28, v28
    v_dot2c_f32_bf16 v89, v29, v29
    v_dot2c_f32_bf16 v90, v30, v30
    v_dot2c_f32_bf16 v91, v31, v31
    v_mov_b32 v92, 0x358637bd
    s_nop 1
    v_add_f32 v88, v88, v89
    v_add_f32 v90, v90, v91
    v_add_f32 v88, v88, v90
    s_nop 1
    v_add_f32_dpp v88, v88, v88 quad_perm:[1,0,3,2] row_mask:0xf bank_mask:0xf
    s_nop 1
    v_add_f32_dpp v88, v88, v88 quad_perm:[2,3,0,1] row_mask:0xf bank_mask:0xf
    s_nop 1
    v_add_f32_dpp v88, v88, v88 row_half_mirror row_mask:0xf bank_mask:0xf
    v_fmac_f32 v92, 0x3b124925, v88
    v_rsq_f32 v88, v92
    s_waitcnt lgkmcnt(0)
    v_lshlrev_b32 v92, 16, v4
    v_and_b32 v93, s10, v4
    v_pk_mul_f32 v[32:33], v[32:33], v[88:89] op_sel_hi:[1,0]
    v_pk_mul_f32 v[92:93], v[92:93], v[32:33]
    v_cvt_pk_bf16_f32 v4, v92, v93
    v_lshlrev_b32 v94, 16, v5
    v_and_b32 v95, s10, v5
    v_pk_mul_f32 v[34:35], v[34:35], v[88:89] op_sel_hi:[1,0]
    v_pk_mul_f32 v[94:95], v[94:95], v[34:35]
    v_cvt_pk_bf16_f32 v5, v94, v95
    v_lshlrev_b32 v96, 16, v6
    v_and_b32 v97, s10, v6
    v_pk_mul_f32 v[36:37], v[36:37], v[88:89] op_sel_hi:[1,0]
    v_pk_mul_f32 v[96:97], v[96:97], v[36:37]
    v_cvt_pk_bf16_f32 v6, v96, v97
    v_lshlrev_b32 v98, 16, v7
    v_and_b32 v99, s10, v7
    v_pk_mul_f32 v[38:39], v[38:39], v[88:89] op_sel_hi:[1,0]
    v_pk_mul_f32 v[98:99], v[98:99], v[38:39]
    v_cvt_pk_bf16_f32 v7, v98, v99
    v_lshlrev_b32 v92, 16, v8
    v_and_b32 v93, s10, v8
    v_pk_mul_f32 v[40:41], v[40:41], v[88:89] op_sel_hi:[1,0]
    v_pk_mul_f32 v[92:93], v[92:93], v[40:41]
    v_cvt_pk_bf16_f32 v8, v92, v93
    v_lshlrev_b32 v94, 16, v9
    v_and_b32 v95, s10, v9
    v_pk_mul_f32 v[42:43], v[42:43], v[88:89] op_sel_hi:[1,0]
    v_pk_mul_f32 v[94:95], v[94:95], v[42:43]
    v_cvt_pk_bf16_f32 v9, v94, v95
    v_lshlrev_b32 v96, 16, v10
    v_and_b32 v97, s10, v10
    v_pk_mul_f32 v[44:45], v[44:45], v[88:89] op_sel_hi:[1,0]
    v_pk_mul_f32 v[96:97], v[96:97], v[44:45]
    v_cvt_pk_bf16_f32 v10, v96, v97
    v_lshlrev_b32 v98, 16, v11
    v_and_b32 v99, s10, v11
    v_pk_mul_f32 v[46:47], v[46:47], v[88:89] op_sel_hi:[1,0]
    v_pk_mul_f32 v[98:99], v[98:99], v[46:47]
    v_cvt_pk_bf16_f32 v11, v98, v99
    v_lshlrev_b32 v92, 16, v12
    v_and_b32 v93, s10, v12
    v_pk_mul_f32 v[48:49], v[48:49], v[88:89] op_sel_hi:[1,0]
    v_pk_mul_f32 v[92:93], v[92:93], v[48:49]
    v_cvt_pk_bf16_f32 v12, v92, v93
    v_lshlrev_b32 v94, 16, v13
    v_and_b32 v95, s10, v13
    v_pk_mul_f32 v[50:51], v[50:51], v[88:89] op_sel_hi:[1,0]
    v_pk_mul_f32 v[94:95], v[94:95], v[50:51]
    v_cvt_pk_bf16_f32 v13, v94, v95
    v_lshlrev_b32 v96, 16, v14
    v_and_b32 v97, s10, v14
    v_pk_mul_f32 v[52:53], v[52:53], v[88:89] op_sel_hi:[1,0]
    v_pk_mul_f32 v[96:97], v[96:97], v[52:53]
    v_cvt_pk_bf16_f32 v14, v96, v97
    v_lshlrev_b32 v98, 16, v15
    v_and_b32 v99, s10, v15
    v_pk_mul_f32 v[54:55], v[54:55], v[88:89] op_sel_hi:[1,0]
    v_pk_mul_f32 v[98:99], v[98:99], v[54:55]
    v_cvt_pk_bf16_f32 v15, v98, v99
    v_lshlrev_b32 v92, 16, v16
    v_and_b32 v93, s10, v16
    v_pk_mul_f32 v[56:57], v[56:57], v[88:89] op_sel_hi:[1,0]
    v_pk_mul_f32 v[92:93], v[92:93], v[56:57]
    v_cvt_pk_bf16_f32 v16, v92, v93
    v_lshlrev_b32 v94, 16, v17
    v_and_b32 v95, s10, v17
    v_pk_mul_f32 v[58:59], v[58:59], v[88:89] op_sel_hi:[1,0]
    v_pk_mul_f32 v[94:95], v[94:95], v[58:59]
    v_cvt_pk_bf16_f32 v17, v94, v95
    v_lshlrev_b32 v96, 16, v18
    v_and_b32 v97, s10, v18
    v_pk_mul_f32 v[60:61], v[60:61], v[88:89] op_sel_hi:[1,0]
    v_pk_mul_f32 v[96:97], v[96:97], v[60:61]
    v_cvt_pk_bf16_f32 v18, v96, v97
    v_lshlrev_b32 v98, 16, v19
    v_and_b32 v99, s10, v19
    v_pk_mul_f32 v[62:63], v[62:63], v[88:89] op_sel_hi:[1,0]
    v_pk_mul_f32 v[98:99], v[98:99], v[62:63]
    v_cvt_pk_bf16_f32 v19, v98, v99
    v_lshlrev_b32 v92, 16, v20
    v_and_b32 v93, s10, v20
    v_pk_mul_f32 v[64:65], v[64:65], v[88:89] op_sel_hi:[1,0]
    v_pk_mul_f32 v[92:93], v[92:93], v[64:65]
    v_cvt_pk_bf16_f32 v20, v92, v93
    v_lshlrev_b32 v94, 16, v21
    v_and_b32 v95, s10, v21
    v_pk_mul_f32 v[66:67], v[66:67], v[88:89] op_sel_hi:[1,0]
    v_pk_mul_f32 v[94:95], v[94:95], v[66:67]
    v_cvt_pk_bf16_f32 v21, v94, v95
    v_lshlrev_b32 v96, 16, v22
    v_and_b32 v97, s10, v22
    v_pk_mul_f32 v[68:69], v[68:69], v[88:89] op_sel_hi:[1,0]
    v_pk_mul_f32 v[96:97], v[96:97], v[68:69]
    v_cvt_pk_bf16_f32 v22, v96, v97
    v_lshlrev_b32 v98, 16, v23
    v_and_b32 v99, s10, v23
    v_pk_mul_f32 v[70:71], v[70:71], v[88:89] op_sel_hi:[1,0]
    v_pk_mul_f32 v[98:99], v[98:99], v[70:71]
    v_cvt_pk_bf16_f32 v23, v98, v99
    v_lshlrev_b32 v92, 16, v24
    v_and_b32 v93, s10, v24
    v_pk_mul_f32 v[72:73], v[72:73], v[88:89] op_sel_hi:[1,0]
    v_pk_mul_f32 v[92:93], v[92:93], v[72:73]
    v_cvt_pk_bf16_f32 v24, v92, v93
    v_lshlrev_b32 v94, 16, v25
    v_and_b32 v95, s10, v25
    v_pk_mul_f32 v[74:75], v[74:75], v[88:89] op_sel_hi:[1,0]
    v_pk_mul_f32 v[94:95], v[94:95], v[74:75]
    v_cvt_pk_bf16_f32 v25, v94, v95
    v_lshlrev_b32 v96, 16, v26
    v_and_b32 v97, s10, v26
    v_pk_mul_f32 v[76:77], v[76:77], v[88:89] op_sel_hi:[1,0]
    v_pk_mul_f32 v[96:97], v[96:97], v[76:77]
    v_cvt_pk_bf16_f32 v26, v96, v97
    v_lshlrev_b32 v98, 16, v27
    v_and_b32 v99, s10, v27
    v_pk_mul_f32 v[78:79], v[78:79], v[88:89] op_sel_hi:[1,0]
    v_pk_mul_f32 v[98:99], v[98:99], v[78:79]
    v_cvt_pk_bf16_f32 v27, v98, v99
    v_lshlrev_b32 v92, 16, v28
    v_and_b32 v93, s10, v28
    v_pk_mul_f32 v[80:81], v[80:81], v[88:89] op_sel_hi:[1,0]
    v_pk_mul_f32 v[92:93], v[92:93], v[80:81]
    v_cvt_pk_bf16_f32 v28, v92, v93
    v_lshlrev_b32 v94, 16, v29
    v_and_b32 v95, s10, v29
    v_pk_mul_f32 v[82:83], v[82:83], v[88:89] op_sel_hi:[1,0]
    v_pk_mul_f32 v[94:95], v[94:95], v[82:83]
    v_cvt_pk_bf16_f32 v29, v94, v95
    v_lshlrev_b32 v96, 16, v30
    v_and_b32 v97, s10, v30
    v_pk_mul_f32 v[84:85], v[84:85], v[88:89] op_sel_hi:[1,0]
    v_pk_mul_f32 v[96:97], v[96:97], v[84:85]
    v_cvt_pk_bf16_f32 v30, v96, v97
    v_lshlrev_b32 v98, 16, v31
    v_and_b32 v99, s10, v31
    v_pk_mul_f32 v[86:87], v[86:87], v[88:89] op_sel_hi:[1,0]
    v_pk_mul_f32 v[98:99], v[98:99], v[86:87]
    v_cvt_pk_bf16_f32 v31, v98, v99
    s_cmp_ge_u32 s11, 12
    s_cbranch_scc1 L_young
    s_barrier
L_young:
    global_store_dwordx4 v1, v[4:7], s[8:9] offset:0 sc0 sc1
    global_store_dwordx4 v1, v[8:11], s[8:9] offset:128 sc0 sc1
    global_store_dwordx4 v1, v[12:15], s[8:9] offset:256 sc0 sc1
    global_store_dwordx4 v1, v[16:19], s[8:9] offset:384 sc0 sc1
    global_store_dwordx4 v1, v[20:23], s[8:9] offset:512 sc0 sc1
    global_store_dwordx4 v1, v[24:27], s[8:9] offset:640 sc0 sc1
    global_store_dwordx4 v1, v[28:31], s[8:9] offset:768 sc0 sc1
L_end:
    s_endpgm
.section .rodata,"a"
.p2align 6
.amdhsa_kernel standalone__rmsnorm__sampling_kernel
  .amdhsa_next_free_vgpr 100
  .amdhsa_next_free_sgpr 16
  .amdhsa_accum_offset 100
  .amdhsa_group_segment_fixed_size 0
  .amdhsa_kernarg_size 40
  .amdhsa_user_sgpr_count 2
  .amdhsa_user_sgpr_kernarg_segment_ptr 1
  .amdhsa_system_sgpr_workgroup_id_x 1
  .amdhsa_float_denorm_mode_32 3
.end_amdhsa_kernel
```
